```python
import torch

def _softmax(x, axis=-1):
    return torch.softmax(x, dim=axis)
def _gelu(x):
    return torch.nn.functional.gelu(x, approximate="tanh")
def _silu(x):
    return torch.nn.functional.silu(x)
def _sigmoid(x):
    return torch.sigmoid(x)
def _layernorm(x, axis=-1, eps=1e-5):
    m = x.mean(dim=axis, keepdim=True)
    v = x.var(dim=axis, keepdim=True, unbiased=False)
    return (x - m) / torch.sqrt(v + eps)
def _scatter_add(tgt, idx, src, axis=0):
    return tgt.clone().index_add_(axis, idx, src)
def _segment_sum(src, seg, n):
    out = torch.zeros((n,) + src.shape[1:], dtype=src.dtype)
    return out.index_add_(0, seg, src)
def _pad(x, pw):
    flat = tuple(v for pair in reversed(pw) for v in pair)
    return torch.nn.functional.pad(x, flat)

kernel_name = 'standalone__mha_block_cached__sampling'

def setup_inputs():

    _w = (lambda a: (lambda t: t.to(torch.bfloat16) if t.is_floating_point() else t)(torch.as_tensor(a)))
    B, Sq, D = 16, 1, 1024
    H, Sk, Dh = 32, 2048, 128
    return {
        "x": _w((lambda *s: torch.randn(*s, dtype=torch.bfloat16) * 0.8)(B, Sq, D)),
        "k_cache": _w((lambda *s: torch.randn(*s, dtype=torch.bfloat16) * 0.8)(B, H, Sk, Dh)),
        "v_cache": _w((lambda *s: torch.randn(*s, dtype=torch.bfloat16) * 0.05)(B, H, Sk, Dh)),
        "wq": _w((lambda *s: torch.randn(*s, dtype=torch.bfloat16) * 0.8)(D, H * Dh) * (D ** -0.5)),
        "wo": _w((lambda *s: torch.randn(*s, dtype=torch.bfloat16) * 0.05)(H * Dh, D) * ((H * Dh) ** -0.5)),
    }

def reference(x, k_cache, v_cache, wq, wo):
    B, Sq, D = x.shape
    H, Dh = 32, 128
    q = (lambda x, *d: x.permute(*d))((x @ wq).reshape(B, Sq, H, Dh), 0, 2, 1, 3)
    scores = torch.einsum("bhqd,bhkd->bhqk", q, k_cache) * (Dh ** -0.5)
    p = _softmax(scores, axis=-1)
    o = torch.einsum("bhqk,bhkd->bhqd", p, v_cache)
    return (lambda x, *d: x.permute(*d))(o, 0, 2, 1, 3).reshape(B, Sq, H * Dh) @ wo
```

```asm
; @launch grid=(256,1,1) block=(512,1,1) lds=57344
.amdgcn_target "amdgcn-amd-amdhsa--gfx950"
.text
.globl standalone__mha_block_cached__sampling_kernel
.p2align 8
.type standalone__mha_block_cached__sampling_kernel,@function
standalone__mha_block_cached__sampling_kernel:
    s_cmp_ge_u32 s2, 256
    s_cbranch_scc1 L_end
    s_load_dwordx16 s[4:19], s[0:1], 0
    s_getpc_b64 s[58:59]
    v_lshlrev_b32 v15, 7, v0
    v_cmp_gt_u32 vcc, 6904, v15
    s_nop 0
    s_and_saveexec_b64 s[64:65], vcc
    s_cbranch_execz L_nocpf
    global_load_dword v236, v15, s[58:59]
L_nocpf:
    s_mov_b64 exec, s[64:65]
    v_lshrrev_b32 v12, 6, v0
    v_and_b32 v1, 63, v0
    v_readfirstlane_b32 s60, v12
    v_lshrrev_b32 v2, 4, v1
    s_and_b32 s61, s2, 7
    s_lshl_b32 s61, s61, 2
    s_bfe_u32 s64, s2, 0x20003
    s_add_u32 s61, s61, s64
    s_lshr_b32 s62, s2, 5
    v_and_b32 v17, 15, v1
    v_lshlrev_b32 v20, 13, v2
    v_lshl_add_u32 v20, v17, 4, v20
    s_lshl_b32 s64, s62, 20
    s_lshl_b32 s66, s60, 17
    s_add_u32 s64, s64, s66
    s_lshl_b32 s66, s61, 8
    s_add_u32 s64, s64, s66
    v_lshlrev_b32 v21, 11, v17
    v_lshl_add_u32 v21, v2, 4, v21
    s_lshl_b32 s66, s62, 8
    s_mov_b32 s39, 0x20000
    s_mov_b32 s47, 0x20000
    s_mov_b32 s38, 8388608
    s_mov_b32 s46, 32768
    v_bfe_u32 v13, v1, 2, 2
    v_and_b32 v14, 3, v1
    v_lshlrev_b32 v3, 8, v13
    v_lshl_add_u32 v3, v2, 6, v3
    v_lshl_add_u32 v3, v14, 4, v3
    s_lshl_b32 s72, s62, 6
    s_add_u32 s72, s72, s61
    s_lshl_b32 s72, s72, 19
    s_mul_i32 s63, s2, 16384
    s_lshl_b32 s67, s60, 12
    s_add_u32 s63, s63, s67
    s_and_b32 s63, s63, 0x7ffff
    s_mov_b32 s22, 0x80000
    s_mov_b32 s23, 0x20000
    s_waitcnt lgkmcnt(0)
    s_mov_b32 s36, s10
    s_mov_b32 s37, s11
    s_mov_b32 s44, s4
    s_mov_b32 s45, s5
    buffer_load_dwordx4 v[176:179], v20, s[36:39], s64 offen nt
    s_add_u32 s64, s64, 0x8000
    buffer_load_dwordx4 v[180:183], v20, s[36:39], s64 offen nt
    s_add_u32 s64, s64, 0x8000
    buffer_load_dwordx4 v[184:187], v20, s[36:39], s64 offen nt
    s_add_u32 s64, s64, 0x8000
    buffer_load_dwordx4 v[188:191], v20, s[36:39], s64 offen nt
    s_and_b32 s67, s60, 3
    s_lshl_b32 s67, s67, 6
    s_add_u32 s66, s66, s67
    buffer_load_dwordx4 v[192:195], v21, s[44:47], s66 offen
    s_barrier
    s_add_u32 s20, s6, s72
    s_addc_u32 s21, s7, 0
    buffer_load_dwordx4 v[48:51], v3, s[20:23], s63 offen offset:0 nt
    buffer_load_dwordx4 v[52:55], v3, s[20:23], s63 offen offset:1024 nt
    buffer_load_dwordx4 v[56:59], v3, s[20:23], s63 offen offset:2048 nt
    buffer_load_dwordx4 v[60:63], v3, s[20:23], s63 offen offset:3072 nt
    s_add_u32 s63, s63, 0x8000
    s_and_b32 s63, s63, 0x7ffff
    buffer_load_dwordx4 v[64:67], v3, s[20:23], s63 offen offset:0 nt
    buffer_load_dwordx4 v[68:71], v3, s[20:23], s63 offen offset:1024 nt
    buffer_load_dwordx4 v[72:75], v3, s[20:23], s63 offen offset:2048 nt
    buffer_load_dwordx4 v[76:79], v3, s[20:23], s63 offen offset:3072 nt
    s_add_u32 s63, s63, 0x8000
    s_and_b32 s63, s63, 0x7ffff
    v_lshlrev_b32 v4, 4, v1
    s_load_dword s69, s[18:19], 0x40000
    s_mov_b32 s27, 0x20000
    s_mov_b32 s43, 0x20000
    s_mov_b32 s51, 0x20000
    s_mov_b32 s55, 0x20000
    s_mov_b32 s26, 524288
    s_mov_b32 s42, 8388608
    s_mov_b32 s50, 4980736
    s_mov_b32 s54, 32768
    s_add_u32 s65, s72, 0x1000000
    s_add_u32 s30, s8, s72
    s_addc_u32 s31, s9, 0
    s_add_u32 s32, s6, s65
    s_addc_u32 s33, s7, 0
    s_add_u32 s34, s8, s65
    s_addc_u32 s35, s9, 0
    s_mov_b64 s[24:25], s[20:21]
    s_mov_b32 s40, s12
    s_mov_b32 s41, s13
    s_mov_b32 s48, s18
    s_mov_b32 s49, s19
    s_mov_b32 s52, s14
    s_mov_b32 s53, s15
    v_and_b32 v12, 1, v1
    v_lshlrev_b32 v12, 4, v12
    v_mov_b32 v13, 0xffff
    v_lshlrev_b32 v12, v12, v13
    v_bfe_u32 v13, v1, 1, 2
    v_cmp_eq_u32 vcc, 0, v13
    s_nop 1
    v_cndmask_b32 v5, 0, v12, vcc
    v_cmp_eq_u32 vcc, 1, v13
    s_nop 1
    v_cndmask_b32 v6, 0, v12, vcc
    v_cmp_eq_u32 vcc, 2, v13
    s_nop 1
    v_cndmask_b32 v7, 0, v12, vcc
    v_cmp_eq_u32 vcc, 3, v13
    s_nop 1
    v_cndmask_b32 v8, 0, v12, vcc
    s_mov_b32 s68, 0x3e0293ee
    s_mov_b32 s70, 0xff
    s_mov_b32 s74, 0xf000f
    s_mov_b32 s75, 0xf000f
    s_mov_b32 s76, 0xf000f0
    s_mov_b32 s77, 0xf000f0
    s_mov_b32 s78, 0xf000f00
    s_mov_b32 s79, 0xf000f00
    s_mov_b32 s80, 0xf000f000
    s_mov_b32 s81, 0xf000f000
    s_lshl_b32 s65, s60, 10
    s_add_u32 s65, s65, 1024
    v_bfe_u32 v13, v1, 2, 2
    v_lshl_add_u32 v9, v13, 2, v2
    v_lshl_add_u32 v9, v9, 2, s65
    v_add_u32 v10, s65, v4
    v_lshl_add_u32 v11, v2, 4, s65
    v_lshlrev_b32 v18, 2, v2
    v_and_b32 v14, 3, v1
    v_add_lshl_u32 v18, v18, v14, 4
    v_lshrrev_b32 v13, 2, v17
    v_lshl_add_u32 v13, v2, 3, v13
    v_mul_u32_u24 v19, 272, v13
    v_lshl_add_u32 v19, v14, 3, v19
    s_lshl_b32 s65, s60, 5
    v_add_u32 v19, s65, v19
    s_mul_i32 s65, s60, 4352
    v_mul_u32_u24 v23, 272, v2
    v_lshl_add_u32 v23, v17, 4, v23
    v_add_u32 v23, s65, v23
    v_lshlrev_b32 v22, 11, v2
    v_lshl_add_u32 v22, v17, 4, v22
    s_lshl_b32 s72, s61, 18
    s_lshl_b32 s65, s60, 15
    s_add_u32 s72, s72, s65
    s_lshl_b32 s65, s62, 8
    s_add_u32 s72, s72, s65
    v_lshlrev_b32 v37, 5, v17
    v_and_b32 v13, 1, v2
    v_lshl_add_u32 v37, v13, 4, v37
    s_lshl_b32 s65, s60, 9
    v_add_u32 v37, s65, v37
    v_lshrrev_b32 v12, 1, v17
    v_lshlrev_b32 v12, 13, v12
    v_and_b32 v13, 1, v17
    v_lshl_add_u32 v12, v13, 9, v12
    v_lshl_add_u32 v12, v2, 4, v12
    s_lshl_b32 s71, s61, 16
    s_add_u32 s71, s71, 2621440
    s_lshl_b32 s64, s62, 10
    s_add_u32 s64, s64, s71
    s_lshl_b32 s65, s60, 6
    s_add_u32 s64, s64, s65
    s_lshl_b32 s65, s62, 13
    s_add_u32 s71, s71, s65
    s_lshl_b32 s65, s60, 10
    s_add_u32 s71, s71, s65
    s_mov_b32 s73, 0
    s_waitcnt vmcnt(12)
    ds_write_b128 v23, v[176:179] offset:22528
    s_waitcnt vmcnt(11)
    ds_write_b128 v23, v[180:183] offset:23616
    s_waitcnt vmcnt(10)
    ds_write_b128 v23, v[184:187] offset:24704
    s_waitcnt vmcnt(9)
    ds_write_b128 v23, v[188:191] offset:25792
    s_and_b32 s67, s60, 3
    s_lshl_b32 s67, s67, 10
    v_add_u32 v13, s67, v4
    s_waitcnt vmcnt(8)
    ds_write_b128 v13, v[192:195] offset:18432
    s_waitcnt lgkmcnt(0)
    s_barrier
    ds_read_b128 v[192:195], v4 offset:18432
    ds_read_b128 v[196:199], v4 offset:19456
    ds_read_b128 v[200:203], v4 offset:20480
    ds_read_b128 v[204:207], v4 offset:21504
    ds_read_b64_tr_b16 v[176:177], v19 offset:22528
    ds_read_b64_tr_b16 v[178:179], v19 offset:23616
    ds_read_b64_tr_b16 v[180:181], v19 offset:31232
    ds_read_b64_tr_b16 v[182:183], v19 offset:32320
    ds_read_b64_tr_b16 v[184:185], v19 offset:39936
    ds_read_b64_tr_b16 v[186:187], v19 offset:41024
    ds_read_b64_tr_b16 v[188:189], v19 offset:48640
    ds_read_b64_tr_b16 v[190:191], v19 offset:49728
    s_and_b32 s69, s69, 0xff
    s_add_u32 s69, s69, 1
    s_cmp_eq_u32 s69, 256
    s_cselect_b32 s69, 1, s69
    v_mov_b32 v236, s69
    s_waitcnt lgkmcnt(6)
    v_mfma_f32_16x16x32_bf16 v[32:35], v[176:179], v[192:195], 0
    s_waitcnt lgkmcnt(4)
    v_mfma_f32_16x16x32_bf16 v[32:35], v[180:183], v[196:199], v[32:35]
    s_waitcnt lgkmcnt(2)
    v_mfma_f32_16x16x32_bf16 v[32:35], v[184:187], v[200:203], v[32:35]
    s_waitcnt lgkmcnt(0)
    v_mfma_f32_16x16x32_bf16 v[32:35], v[188:191], v[204:207], v[32:35]
    s_nop 7
    v_bfi_b32 v32, s70, v236, v32
    v_bfi_b32 v33, s70, v236, v33
    v_bfi_b32 v34, s70, v236, v34
    v_bfi_b32 v35, s70, v236, v35
    buffer_store_dwordx4 v[32:35], v12, s[48:51], s64 offen sc1 nt
    s_waitcnt vmcnt(3)
    buffer_load_dwordx4 v[80:83], v3, s[20:23], s63 offen offset:0 nt
    s_waitcnt vmcnt(3)
    buffer_load_dwordx4 v[84:87], v3, s[20:23], s63 offen offset:1024 nt
    s_waitcnt vmcnt(3)
    buffer_load_dwordx4 v[88:91], v3, s[20:23], s63 offen offset:2048 nt
    s_waitcnt vmcnt(2)
    buffer_load_dwordx4 v[92:95], v3, s[20:23], s63 offen offset:3072 nt
    s_add_u32 s63, s63, 0x8000
    s_and_b32 s63, s63, 0x7ffff
    s_waitcnt vmcnt(2)
    buffer_load_dwordx4 v[220:223], v22, s[40:43], s72 offen nt
    s_add_u32 s72, s72, 8192
    s_waitcnt vmcnt(2)
    buffer_load_dwordx4 v[224:227], v22, s[40:43], s72 offen nt
    s_add_u32 s72, s72, 8192
    s_waitcnt vmcnt(2)
    buffer_load_dwordx4 v[228:231], v22, s[40:43], s72 offen nt
    s_add_u32 s72, s72, 8192
    s_waitcnt vmcnt(2)
    buffer_load_dwordx4 v[232:235], v22, s[40:43], s72 offen nt
    s_add_u32 s72, s72, 8192
    s_waitcnt vmcnt(2)
    buffer_load_dwordx4 v[96:99], v3, s[20:23], s63 offen offset:0 nt
    s_waitcnt vmcnt(2)
    buffer_load_dwordx4 v[100:103], v3, s[20:23], s63 offen offset:1024 nt
    s_waitcnt vmcnt(2)
    buffer_load_dwordx4 v[104:107], v3, s[20:23], s63 offen offset:2048 nt
    s_waitcnt vmcnt(2)
    buffer_load_dwordx4 v[108:111], v3, s[20:23], s63 offen offset:3072 nt
    s_add_u32 s63, s63, 0x8000
    s_and_b32 s63, s63, 0x7ffff
    s_waitcnt vmcnt(2)
    buffer_load_dwordx4 v[112:115], v3, s[20:23], s63 offen offset:0 nt
    s_waitcnt vmcnt(2)
    buffer_load_dwordx4 v[116:119], v3, s[20:23], s63 offen offset:1024 nt
    s_waitcnt vmcnt(2)
    buffer_load_dwordx4 v[120:123], v3, s[20:23], s63 offen offset:2048 nt
    s_waitcnt vmcnt(2)
    buffer_load_dwordx4 v[124:127], v3, s[20:23], s63 offen offset:3072 nt
    s_add_u32 s63, s63, 0x8000
    s_and_b32 s63, s63, 0x7ffff
    s_waitcnt vmcnt(2)
    buffer_load_dwordx4 v[128:131], v3, s[20:23], s63 offen offset:0 nt
    s_waitcnt vmcnt(2)
    buffer_load_dwordx4 v[132:135], v3, s[20:23], s63 offen offset:1024 nt
    s_waitcnt vmcnt(2)
    buffer_load_dwordx4 v[136:139], v3, s[20:23], s63 offen offset:2048 nt
    s_waitcnt vmcnt(2)
    buffer_load_dwordx4 v[140:143], v3, s[20:23], s63 offen offset:3072 nt
    s_add_u32 s63, s63, 0x8000
    s_and_b32 s63, s63, 0x7ffff
    s_waitcnt vmcnt(2)
    buffer_load_dwordx4 v[40:43], v4, s[48:51], s71 offen sc1
    buffer_load_dwordx4 v[144:147], v3, s[20:23], s63 offen offset:0 nt
    s_waitcnt vmcnt(3)
    buffer_load_dwordx4 v[148:151], v3, s[20:23], s63 offen offset:1024 nt
    s_waitcnt vmcnt(3)
    buffer_load_dwordx4 v[152:155], v3, s[20:23], s63 offen offset:2048 nt
    s_waitcnt vmcnt(2)
    s_cmp_lg_u32 s73, 0
    s_cbranch_scc1 L_pc0
    v_msad_u8 v13, v40, v236, 0
    v_msad_u8 v13, v41, v236, v13
    v_msad_u8 v13, v42, v236, v13
    v_msad_u8 v13, v43, v236, v13
    v_cmp_ne_u32 vcc, 0, v13
    s_cbranch_vccnz L_pc0
    ds_write_b128 v10, v[40:43]
    s_mov_b32 s73, 1
    s_mov_b32 s71, 0x7fff0000
L_pc0:
    buffer_load_dwordx4 v[156:159], v3, s[20:23], s63 offen offset:3072 nt
    s_add_u32 s63, s63, 0x8000
    s_and_b32 s63, s63, 0x7ffff
    s_waitcnt vmcnt(2)
    buffer_load_dwordx4 v[44:47], v4, s[48:51], s71 offen sc1
    buffer_load_dwordx4 v[160:163], v3, s[20:23], s63 offen offset:0 nt
    s_waitcnt vmcnt(3)
    buffer_load_dwordx4 v[164:167], v3, s[20:23], s63 offen offset:1024 nt
    s_waitcnt vmcnt(3)
    buffer_load_dwordx4 v[168:171], v3, s[20:23], s63 offen offset:2048 nt
    s_waitcnt vmcnt(2)
    s_cmp_lg_u32 s73, 0
    s_cbranch_scc1 L_pc1
    v_msad_u8 v13, v44, v236, 0
    v_msad_u8 v13, v45, v236, v13
    v_msad_u8 v13, v46, v236, v13
    v_msad_u8 v13, v47, v236, v13
    v_cmp_ne_u32 vcc, 0, v13
    s_cbranch_vccnz L_pc1
    ds_write_b128 v10, v[44:47]
    s_mov_b32 s73, 1
    s_mov_b32 s71, 0x7fff0000
L_pc1:
    buffer_load_dwordx4 v[172:175], v3, s[20:23], s63 offen offset:3072 nt
    s_add_u32 s63, s63, 0x8000
    s_and_b32 s63, s63, 0x7ffff
    s_cmp_lg_u32 s73, 0
    s_cbranch_scc1 L_qok
    s_mov_b32 s73, 0x20000
L_pollq:
    s_sub_u32 s73, s73, 1
    s_cbranch_scc1 L_qok
    buffer_load_dwordx4 v[40:43], v4, s[48:51], s71 offen sc1
    s_waitcnt vmcnt(0)
    v_msad_u8 v13, v40, v236, 0
    v_msad_u8 v13, v41, v236, v13
    v_msad_u8 v13, v42, v236, v13
    v_msad_u8 v13, v43, v236, v13
    v_cmp_ne_u32 vcc, 0, v13
    s_cbranch_vccnz L_pollq
    ds_write_b128 v10, v[40:43]
    s_mov_b32 s73, 1
    s_mov_b32 s71, 0x7fff0000
L_qok:
    s_waitcnt lgkmcnt(0)
    s_barrier
    s_cmp_ge_u32 s60, 2
    s_cbranch_scc1 L_q2
    s_lshl_b32 s65, s60, 9
    v_lshl_add_u32 v12, v1, 3, s65
    ds_read_b64 v[176:177], v12 offset:1024
    ds_read_b64 v[178:179], v12 offset:2048
    ds_read_b64 v[180:181], v12 offset:3072
    ds_read_b64 v[182:183], v12 offset:4096
    ds_read_b64 v[184:185], v12 offset:5120
    ds_read_b64 v[186:187], v12 offset:6144
    ds_read_b64 v[188:189], v12 offset:7168
    ds_read_b64 v[190:191], v12 offset:8192
    s_lshl_b32 s65, s60, 8
    v_lshl_add_u32 v13, v1, 2, s65
    s_waitcnt lgkmcnt(0)
    v_add_f32 v176, v176, v184
    v_add_f32 v177, v177, v185
    v_add_f32 v178, v178, v186
    v_add_f32 v179, v179, v187
    v_add_f32 v180, v180, v188
    v_add_f32 v181, v181, v189
    v_add_f32 v182, v182, v190
    v_add_f32 v183, v183, v191
    v_add_f32 v176, v176, v180
    v_add_f32 v177, v177, v181
    v_add_f32 v178, v178, v182
    v_add_f32 v179, v179, v183
    v_add_f32 v176, v176, v178
    v_add_f32 v177, v177, v179
    v_cvt_pk_bf16_f32 v176, v176, v177
    ds_write_b32 v13, v176 offset:0
L_q2:
    v_mov_b32 v238, 0
    ds_write_b32 v238, v238 offset:768
    ds_write_b32 v238, v238 offset:772
    ds_write_b128 v23, v[220:223] offset:22528
    ds_write_b128 v23, v[224:227] offset:23616
    ds_write_b128 v23, v[228:231] offset:24704
    ds_write_b128 v23, v[232:235] offset:25792
    s_waitcnt lgkmcnt(0)
    s_barrier
    ds_read_b128 v[212:215], v18 offset:0
    s_waitcnt lgkmcnt(0)
    v_cndmask_b32 v176, 0, v212, s[74:75]
    v_cndmask_b32 v177, 0, v213, s[74:75]
    v_cndmask_b32 v178, 0, v214, s[74:75]
    v_cndmask_b32 v179, 0, v215, s[74:75]
    v_cndmask_b32 v180, 0, v212, s[76:77]
    v_cndmask_b32 v181, 0, v213, s[76:77]
    v_cndmask_b32 v182, 0, v214, s[76:77]
    v_cndmask_b32 v183, 0, v215, s[76:77]
    v_cndmask_b32 v184, 0, v212, s[78:79]
    v_cndmask_b32 v185, 0, v213, s[78:79]
    v_cndmask_b32 v186, 0, v214, s[78:79]
    v_cndmask_b32 v187, 0, v215, s[78:79]
    v_cndmask_b32 v188, 0, v212, s[80:81]
    v_cndmask_b32 v189, 0, v213, s[80:81]
    v_cndmask_b32 v190, 0, v214, s[80:81]
    v_cndmask_b32 v191, 0, v215, s[80:81]
    v_mov_b32 v16, 0xff800000
    v_mov_b32 v36, v3
    s_mov_b32 s57, 0
    s_mov_b32 s28, 0
    v_mov_b32 v237, 0
    s_mov_b32 s3, 0
    s_mul_i32 s36, s60, 4
    s_mov_b32 s37, 0x7fff0000
    s_lshl_b32 s38, s2, 7
    s_add_u32 s38, s38, 0x60000
    s_and_b32 s39, s38, 0xfffffc00
    v_lshlrev_b32 v239, 7, v1
    s_and_b32 s64, s2, 7
    v_cmp_eq_u32 vcc, s64, v1
    v_cmp_lt_u32 s[66:67], 7, v1
    s_nop 0
    s_or_b64 vcc, vcc, s[66:67]
    v_mov_b32 v240, 0x7f000000
    v_cndmask_b32 v239, v239, v240, vcc
    v_mfma_f32_16x16x32_bf16 v[24:27], v[176:179], v[48:51], 0
    buffer_load_dwordx4 v[48:51], v3, s[20:23], s63 offen offset:0 nt
    v_mfma_f32_16x16x32_bf16 v[24:27], v[180:183], v[52:55], v[24:27]
    v_mfma_f32_16x16x32_bf16 v[24:27], v[184:187], v[56:59], v[24:27]
    v_mfma_f32_16x16x32_bf16 v[24:27], v[188:191], v[60:63], v[24:27]
    s_nop 7
    v_mov_b32_dpp v12, v24 quad_perm:[0,0,0,0] row_mask:0xf bank_mask:0xf
    v_mov_b32_dpp v13, v25 quad_perm:[1,1,1,1] row_mask:0xf bank_mask:0xf
    v_mov_b32_dpp v14, v26 quad_perm:[2,2,2,2] row_mask:0xf bank_mask:0xf
    v_mov_b32_dpp v15, v27 quad_perm:[3,3,3,3] row_mask:0xf bank_mask:0xf
    v_add_f32 v12, v12, v13
    v_add_f32 v14, v14, v15
    v_add_f32 v12, v12, v14
    v_max_f32 v16, v16, v12
    ds_write_b32 v9, v12 offset:0
    v_mfma_f32_16x16x32_bf16 v[24:27], v[176:179], v[64:67], 0
    v_mfma_f32_16x16x32_bf16 v[24:27], v[180:183], v[68:71], v[24:27]
    buffer_load_dwordx4 v[52:55], v3, s[20:23], s63 offen offset:1024 nt
    v_mfma_f32_16x16x32_bf16 v[24:27], v[184:187], v[72:75], v[24:27]
    v_mfma_f32_16x16x32_bf16 v[24:27], v[188:191], v[76:79], v[24:27]
    s_nop 7
    v_mov_b32_dpp v12, v24 quad_perm:[0,0,0,0] row_mask:0xf bank_mask:0xf
    v_mov_b32_dpp v13, v25 quad_perm:[1,1,1,1] row_mask:0xf bank_mask:0xf
    v_mov_b32_dpp v14, v26 quad_perm:[2,2,2,2] row_mask:0xf bank_mask:0xf
    v_mov_b32_dpp v15, v27 quad_perm:[3,3,3,3] row_mask:0xf bank_mask:0xf
    v_add_f32 v12, v12, v13
    v_add_f32 v14, v14, v15
    v_add_f32 v12, v12, v14
    v_max_f32 v16, v16, v12
    ds_write_b32 v9, v12 offset:64
    v_mfma_f32_16x16x32_bf16 v[24:27], v[176:179], v[80:83], 0
    v_mfma_f32_16x16x32_bf16 v[24:27], v[180:183], v[84:87], v[24:27]
    v_mfma_f32_16x16x32_bf16 v[24:27], v[184:187], v[88:91], v[24:27]
    buffer_load_dwordx4 v[56:59], v3, s[20:23], s63 offen offset:2048 nt
    v_mfma_f32_16x16x32_bf16 v[24:27], v[188:191], v[92:95], v[24:27]
    s_nop 7
    v_mov_b32_dpp v12, v24 quad_perm:[0,0,0,0] row_mask:0xf bank_mask:0xf
    v_mov_b32_dpp v13, v25 quad_perm:[1,1,1,1] row_mask:0xf bank_mask:0xf
    v_mov_b32_dpp v14, v26 quad_perm:[2,2,2,2] row_mask:0xf bank_mask:0xf
    v_mov_b32_dpp v15, v27 quad_perm:[3,3,3,3] row_mask:0xf bank_mask:0xf
    v_add_f32 v12, v12, v13
    v_add_f32 v14, v14, v15
    v_add_f32 v12, v12, v14
    v_max_f32 v16, v16, v12
    ds_write_b32 v9, v12 offset:128
    v_mfma_f32_16x16x32_bf16 v[24:27], v[176:179], v[96:99], 0
    v_mfma_f32_16x16x32_bf16 v[24:27], v[180:183], v[100:103], v[24:27]
    v_mfma_f32_16x16x32_bf16 v[24:27], v[184:187], v[104:107], v[24:27]
    v_mfma_f32_16x16x32_bf16 v[24:27], v[188:191], v[108:111], v[24:27]
    s_nop 7
    v_mov_b32_dpp v12, v24 quad_perm:[0,0,0,0] row_mask:0xf bank_mask:0xf
    v_mov_b32_dpp v13, v25 quad_perm:[1,1,1,1] row_mask:0xf bank_mask:0xf
    v_mov_b32_dpp v14, v26 quad_perm:[2,2,2,2] row_mask:0xf bank_mask:0xf
    v_mov_b32_dpp v15, v27 quad_perm:[3,3,3,3] row_mask:0xf bank_mask:0xf
    v_add_f32 v12, v12, v13
    v_add_f32 v14, v14, v15
    v_add_f32 v12, v12, v14
    v_max_f32 v16, v16, v12
    ds_write_b32 v9, v12 offset:192
    v_mfma_f32_16x16x32_bf16 v[24:27], v[176:179], v[112:115], 0
    v_mfma_f32_16x16x32_bf16 v[24:27], v[180:183], v[116:119], v[24:27]
    v_mfma_f32_16x16x32_bf16 v[24:27], v[184:187], v[120:123], v[24:27]
    v_mfma_f32_16x16x32_bf16 v[24:27], v[188:191], v[124:127], v[24:27]
    s_nop 7
    v_mov_b32_dpp v12, v24 quad_perm:[0,0,0,0] row_mask:0xf bank_mask:0xf
    v_mov_b32_dpp v13, v25 quad_perm:[1,1,1,1] row_mask:0xf bank_mask:0xf
    v_mov_b32_dpp v14, v26 quad_perm:[2,2,2,2] row_mask:0xf bank_mask:0xf
    v_mov_b32_dpp v15, v27 quad_perm:[3,3,3,3] row_mask:0xf bank_mask:0xf
    v_add_f32 v12, v12, v13
    v_add_f32 v14, v14, v15
    v_add_f32 v12, v12, v14
    v_max_f32 v16, v16, v12
    ds_write_b32 v9, v12 offset:256
    v_mfma_f32_16x16x32_bf16 v[24:27], v[176:179], v[128:131], 0
    v_mfma_f32_16x16x32_bf16 v[24:27], v[180:183], v[132:135], v[24:27]
    v_mfma_f32_16x16x32_bf16 v[24:27], v[184:187], v[136:139], v[24:27]
    v_mfma_f32_16x16x32_bf16 v[24:27], v[188:191], v[140:143], v[24:27]
    s_nop 7
    v_mov_b32_dpp v12, v24 quad_perm:[0,0,0,0] row_mask:0xf bank_mask:0xf
    v_mov_b32_dpp v13, v25 quad_perm:[1,1,1,1] row_mask:0xf bank_mask:0xf
    v_mov_b32_dpp v14, v26 quad_perm:[2,2,2,2] row_mask:0xf bank_mask:0xf
    v_mov_b32_dpp v15, v27 quad_perm:[3,3,3,3] row_mask:0xf bank_mask:0xf
    v_add_f32 v12, v12, v13
    v_add_f32 v14, v14, v15
    v_add_f32 v12, v12, v14
    v_max_f32 v16, v16, v12
    ds_write_b32 v9, v12 offset:320
    v_mfma_f32_16x16x32_bf16 v[24:27], v[176:179], v[144:147], 0
    v_mfma_f32_16x16x32_bf16 v[24:27], v[180:183], v[148:151], v[24:27]
    v_mfma_f32_16x16x32_bf16 v[24:27], v[184:187], v[152:155], v[24:27]
    v_mfma_f32_16x16x32_bf16 v[24:27], v[188:191], v[156:159], v[24:27]
    s_nop 7
    v_mov_b32_dpp v12, v24 quad_perm:[0,0,0,0] row_mask:0xf bank_mask:0xf
    v_mov_b32_dpp v13, v25 quad_perm:[1,1,1,1] row_mask:0xf bank_mask:0xf
    v_mov_b32_dpp v14, v26 quad_perm:[2,2,2,2] row_mask:0xf bank_mask:0xf
    v_mov_b32_dpp v15, v27 quad_perm:[3,3,3,3] row_mask:0xf bank_mask:0xf
    v_add_f32 v12, v12, v13
    v_add_f32 v14, v14, v15
    v_add_f32 v12, v12, v14
    v_max_f32 v16, v16, v12
    ds_write_b32 v9, v12 offset:384
    v_mfma_f32_16x16x32_bf16 v[24:27], v[176:179], v[160:163], 0
    s_waitcnt vmcnt(5)
    v_mfma_f32_16x16x32_bf16 v[24:27], v[180:183], v[164:167], v[24:27]
    s_waitcnt vmcnt(4)
    v_mfma_f32_16x16x32_bf16 v[24:27], v[184:187], v[168:171], v[24:27]
    s_waitcnt vmcnt(3)
    v_mfma_f32_16x16x32_bf16 v[24:27], v[188:191], v[172:175], v[24:27]
    buffer_load_dwordx4 v[60:63], v3, s[20:23], s63 offen offset:3072 nt
    s_add_u32 s63, s63, 0x8000
    s_and_b32 s63, s63, 0x7ffff
    s_nop 4
    v_mov_b32_dpp v12, v24 quad_perm:[0,0,0,0] row_mask:0xf bank_mask:0xf
    v_mov_b32_dpp v13, v25 quad_perm:[1,1,1,1] row_mask:0xf bank_mask:0xf
    v_mov_b32_dpp v14, v26 quad_perm:[2,2,2,2] row_mask:0xf bank_mask:0xf
    v_mov_b32_dpp v15, v27 quad_perm:[3,3,3,3] row_mask:0xf bank_mask:0xf
    v_add_f32 v12, v12, v13
    v_add_f32 v14, v14, v15
    v_add_f32 v12, v12, v14
    v_max_f32 v16, v16, v12
    ds_write_b32 v9, v12 offset:448
    v_add_u32 v38, 512, v9
    s_mov_b32 s56, 4
L_kloop:
    s_cmp_lg_u32 s56, 1
    s_cbranch_scc1 L_k1
    s_cmp_eq_u32 s57, 0
    s_cselect_b64 s[24:25], s[30:31], s[34:35]
    v_mov_b32 v36, v4
L_k1:
    s_waitcnt lgkmcnt(0)
    v_readfirstlane_b32 s29, v237
    s_cmp_lg_u32 s3, 1
    s_cbranch_scc1 L_t1k
    v_sub_u32 v240, v240, v242
    v_and_b32 v240, 0xffffc0ff, v240
    v_cmp_eq_u32 vcc, 0, v240
    s_nop 0
    s_bcnt1_i32_b64 s65, vcc
    s_mov_b32 s64, 0x8800
    s_cmp_ge_u32 s65, 2
    s_cselect_b32 s64, 0x0, s64
    s_cmp_ge_u32 s65, 6
    s_cselect_b32 s64, 0x88, s64
    s_cmp_ge_u32 s65, 7
    s_cselect_b32 s64, 0xaa, s64
    v_mov_b32 v237, s64
    ds_write_b32 v238, v237 offset:768
L_t1k:
    s_and_b32 s64, s28, 31
    s_add_u32 s28, s28, 1
    s_cmp_eq_u32 s64, s36
    s_cselect_b32 s3, 1, 0
    s_cselect_b32 s64, s38, s37
    s_cselect_b32 s65, s39, s37
    v_lshl_or_b32 v242, s28, 8, v236
    s_mov_b64 exec, 1
    buffer_store_dword v242, off, s[48:51], s64 sc1
    s_mov_b64 exec, -1
    buffer_load_dword v240, v239, s[48:51], s65 offen sc1
    ds_read_b32 v237, v238 offset:768
    s_waitcnt vmcnt(5)
    v_mfma_f32_16x16x32_bf16 v[24:27], v[176:179], v[48:51], 0
    s_bitcmp1_b32 s29, 0
    s_cbranch_scc1 L_thk0
    s_waitcnt vmcnt(4)
L_thk0:
    buffer_load_dwordx4 v[64:67], v3, s[20:23], s63 offen offset:0 nt
    s_waitcnt vmcnt(5)
    v_mfma_f32_16x16x32_bf16 v[24:27], v[180:183], v[52:55], v[24:27]
    s_bitcmp1_b32 s29, 1
    s_cbranch_scc1 L_thk1
    s_waitcnt vmcnt(4)
L_thk1:
    buffer_load_dwordx4 v[68:71], v3, s[20:23], s63 offen offset:1024 nt
    s_waitcnt vmcnt(5)
    v_mfma_f32_16x16x32_bf16 v[24:27], v[184:187], v[56:59], v[24:27]
    s_bitcmp1_b32 s29, 2
    s_cbranch_scc1 L_thk2
    s_waitcnt vmcnt(4)
L_thk2:
    buffer_load_dwordx4 v[72:75], v3, s[20:23], s63 offen offset:2048 nt
    s_waitcnt vmcnt(5)
    v_mfma_f32_16x16x32_bf16 v[24:27], v[188:191], v[60:63], v[24:27]
    s_bitcmp1_b32 s29, 3
    s_cbranch_scc1 L_thk3
    s_waitcnt vmcnt(2)
    s_bitcmp1_b32 s29, 11
    s_cbranch_scc0 L_thk3
    s_waitcnt vmcnt(1)
L_thk3:
    buffer_load_dwordx4 v[76:79], v3, s[20:23], s63 offen offset:3072 nt
    s_add_u32 s63, s63, 0x8000
    s_and_b32 s63, s63, 0x7ffff
    v_mov_b32_dpp v12, v24 quad_perm:[0,0,0,0] row_mask:0xf bank_mask:0xf
    v_mov_b32_dpp v13, v25 quad_perm:[1,1,1,1] row_mask:0xf bank_mask:0xf
    v_mov_b32_dpp v14, v26 quad_perm:[2,2,2,2] row_mask:0xf bank_mask:0xf
    v_mov_b32_dpp v15, v27 quad_perm:[3,3,3,3] row_mask:0xf bank_mask:0xf
    v_add_f32 v12, v12, v13
    v_add_f32 v14, v14, v15
    v_add_f32 v12, v12, v14
    v_max_f32 v16, v16, v12
    ds_write_b32 v38, v12 offset:0
    s_waitcnt vmcnt(3)
    v_mfma_f32_16x16x32_bf16 v[24:27], v[176:179], v[64:67], 0
    s_bitcmp1_b32 s29, 4
    s_cbranch_scc1 L_thk4
    s_waitcnt vmcnt(2)
L_thk4:
    buffer_load_dwordx4 v[48:51], v36, s[24:27], s63 offen offset:0 nt
    s_waitcnt vmcnt(3)
    v_mfma_f32_16x16x32_bf16 v[24:27], v[180:183], v[68:71], v[24:27]
    s_bitcmp1_b32 s29, 5
    s_cbranch_scc1 L_thk5
    s_waitcnt vmcnt(2)
L_thk5:
    buffer_load_dwordx4 v[52:55], v36, s[24:27], s63 offen offset:1024 nt
    s_waitcnt vmcnt(3)
    v_mfma_f32_16x16x32_bf16 v[24:27], v[184:187], v[72:75], v[24:27]
    s_bitcmp1_b32 s29, 6
    s_cbranch_scc1 L_thk6
    s_waitcnt vmcnt(2)
L_thk6:
    buffer_load_dwordx4 v[56:59], v36, s[24:27], s63 offen offset:2048 nt
    s_waitcnt vmcnt(3)
    v_mfma_f32_16x16x32_bf16 v[24:27], v[188:191], v[76:79], v[24:27]
    s_bitcmp1_b32 s29, 7
    s_cbranch_scc1 L_thk7
    s_waitcnt vmcnt(2)
    s_bitcmp1_b32 s29, 15
    s_cbranch_scc0 L_thk7
    s_waitcnt vmcnt(1)
L_thk7:
    buffer_load_dwordx4 v[60:63], v36, s[24:27], s63 offen offset:3072 nt
    s_add_u32 s63, s63, 0x8000
    s_and_b32 s63, s63, 0x7ffff
    v_mov_b32_dpp v12, v24 quad_perm:[0,0,0,0] row_mask:0xf bank_mask:0xf
    v_mov_b32_dpp v13, v25 quad_perm:[1,1,1,1] row_mask:0xf bank_mask:0xf
    v_mov_b32_dpp v14, v26 quad_perm:[2,2,2,2] row_mask:0xf bank_mask:0xf
    v_mov_b32_dpp v15, v27 quad_perm:[3,3,3,3] row_mask:0xf bank_mask:0xf
    v_add_f32 v12, v12, v13
    v_add_f32 v14, v14, v15
    v_add_f32 v12, v12, v14
    v_max_f32 v16, v16, v12
    ds_write_b32 v38, v12 offset:64
    v_add_u32 v38, 128, v38
    s_sub_u32 s56, s56, 1
    s_cmp_lg_u32 s56, 0
    s_cbranch_scc1 L_kloop
    ds_read_b128 v[208:211], v10
    v_max_f32_dpp v16, v16, v16 row_ror:4 row_mask:0xf bank_mask:0xf
    s_nop 1
    v_max_f32_dpp v16, v16, v16 row_ror:8 row_mask:0xf bank_mask:0xf
    s_nop 0
    v_readlane_b32 s64, v16, 0
    v_readlane_b32 s65, v16, 16
    v_readlane_b32 s66, v16, 32
    v_readlane_b32 s67, v16, 48
    v_mov_b32 v16, s64
    v_max_f32 v16, s65, v16
    v_max_f32 v16, s66, v16
    v_max_f32 v16, s67, v16
    v_mul_f32 v216, s68, v16
    s_waitcnt lgkmcnt(0)
    v_fma_f32 v208, v208, s68, -v216
    v_fma_f32 v209, v209, s68, -v216
    v_fma_f32 v210, v210, s68, -v216
    v_fma_f32 v211, v211, s68, -v216
    v_exp_f32 v208, v208
    v_exp_f32 v209, v209
    v_exp_f32 v210, v210
    v_exp_f32 v211, v211
    v_cvt_pk_bf16_f32 v212, v208, v208
    v_cvt_pk_bf16_f32 v213, v209, v209
    v_cvt_pk_bf16_f32 v214, v210, v210
    v_cvt_pk_bf16_f32 v215, v211, v211
    ds_write_b128 v10, v[212:215]
    ds_read_b128 v[200:203], v11
    ds_read_b128 v[204:207], v11 offset:64
    v_add_f32 v208, v208, v209
    v_add_f32 v210, v210, v211
    v_add_f32 v217, v208, v210
    s_nop 1
    v_add_f32_dpp v217, v217, v217 quad_perm:[1,0,3,2] row_mask:0xf bank_mask:0xf
    s_nop 1
    v_add_f32_dpp v217, v217, v217 quad_perm:[2,3,0,1] row_mask:0xf bank_mask:0xf
    s_nop 1
    v_add_f32_dpp v217, v217, v217 row_ror:4 row_mask:0xf bank_mask:0xf
    s_nop 1
    v_add_f32_dpp v217, v217, v217 row_ror:8 row_mask:0xf bank_mask:0xf
    s_nop 0
    v_readlane_b32 s64, v217, 0
    v_readlane_b32 s65, v217, 16
    v_readlane_b32 s66, v217, 32
    v_readlane_b32 s67, v217, 48
    v_mov_b32 v217, s64
    v_add_f32 v217, s65, v217
    v_add_f32 v217, s66, v217
    v_add_f32 v217, s67, v217
    s_lshl_b32 s64, s60, 3
    s_lshl_b32 s65, s57, 6
    s_add_u32 s64, s64, s65
    v_mov_b32 v12, s64
    ds_write_b64 v12, v[216:217] offset:17920
    v_mov_b32 v28, 0
    v_mov_b32 v29, 0
    v_mov_b32 v30, 0
    v_mov_b32 v31, 0
    v_mov_b32 v39, v11
    s_mov_b64 s[20:21], s[24:25]
    s_mov_b32 s56, 8
L_vloop:
    s_cmp_lg_u32 s56, 1
    s_cbranch_scc1 L_v1
    s_mov_b64 s[24:25], s[32:33]
    s_cmp_eq_u32 s57, 0
    s_cselect_b32 s26, 0x80000, 0
    v_mov_b32 v36, v3
L_v1:
    s_waitcnt lgkmcnt(0)
    v_readfirstlane_b32 s29, v237
    s_cmp_lg_u32 s3, 1
    s_cbranch_scc1 L_t1v
    v_sub_u32 v240, v240, v242
    v_and_b32 v240, 0xffffc0ff, v240
    v_cmp_eq_u32 vcc, 0, v240
    s_nop 0
    s_bcnt1_i32_b64 s65, vcc
    s_mov_b32 s64, 0x8800
    s_cmp_ge_u32 s65, 2
    s_cselect_b32 s64, 0x0, s64
    s_cmp_ge_u32 s65, 6
    s_cselect_b32 s64, 0x88, s64
    s_cmp_ge_u32 s65, 7
    s_cselect_b32 s64, 0xaa, s64
    v_mov_b32 v237, s64
    ds_write_b32 v238, v237 offset:768
L_t1v:
    s_and_b32 s64, s28, 31
    s_add_u32 s28, s28, 1
    s_cmp_eq_u32 s64, s36
    s_cselect_b32 s3, 1, 0
    s_cselect_b32 s64, s38, s37
    s_cselect_b32 s65, s39, s37
    v_lshl_or_b32 v242, s28, 8, v236
    s_mov_b64 exec, 1
    buffer_store_dword v242, off, s[48:51], s64 sc1
    s_mov_b64 exec, -1
    buffer_load_dword v240, v239, s[48:51], s65 offen sc1
    ds_read_b32 v237, v238 offset:768
    v_and_b32 v192, v200, v5
    v_and_b32 v193, v200, v6
    v_and_b32 v194, v200, v7
    v_and_b32 v195, v200, v8
    v_and_b32 v196, v201, v5
    v_and_b32 v197, v201, v6
    v_and_b32 v198, v201, v7
    v_and_b32 v199, v201, v8
    s_waitcnt vmcnt(5)
    v_mfma_f32_16x16x32_bf16 v[28:31], v[192:195], v[48:51], v[28:31]
    s_bitcmp1_b32 s29, 0
    s_cbranch_scc1 L_thv0
    s_waitcnt vmcnt(4)
L_thv0:
    buffer_load_dwordx4 v[64:67], v4, s[20:23], s63 offen offset:0 nt
    v_and_b32 v192, v202, v5
    v_and_b32 v193, v202, v6
    v_and_b32 v194, v202, v7
    v_and_b32 v195, v202, v8
    s_waitcnt vmcnt(5)
    v_mfma_f32_16x16x32_bf16 v[28:31], v[196:199], v[52:55], v[28:31]
    s_bitcmp1_b32 s29, 1
    s_cbranch_scc1 L_thv1
    s_waitcnt vmcnt(4)
L_thv1:
    buffer_load_dwordx4 v[68:71], v4, s[20:23], s63 offen offset:1024 nt
    v_and_b32 v196, v203, v5
    v_and_b32 v197, v203, v6
    v_and_b32 v198, v203, v7
    v_and_b32 v199, v203, v8
    s_waitcnt vmcnt(5)
    v_mfma_f32_16x16x32_bf16 v[28:31], v[192:195], v[56:59], v[28:31]
    s_bitcmp1_b32 s29, 2
    s_cbranch_scc1 L_thv2
    s_waitcnt vmcnt(4)
L_thv2:
    buffer_load_dwordx4 v[72:75], v4, s[20:23], s63 offen offset:2048 nt
    ds_read_b128 v[200:203], v39 offset:128
    v_and_b32 v192, v204, v5
    v_and_b32 v193, v204, v6
    v_and_b32 v194, v204, v7
    v_and_b32 v195, v204, v8
    s_waitcnt vmcnt(5)
    v_mfma_f32_16x16x32_bf16 v[28:31], v[196:199], v[60:63], v[28:31]
    s_bitcmp1_b32 s29, 3
    s_cbranch_scc1 L_thv3
    s_waitcnt vmcnt(2)
    s_bitcmp1_b32 s29, 11
    s_cbranch_scc0 L_thv3
    s_waitcnt vmcnt(1)
L_thv3:
    buffer_load_dwordx4 v[76:79], v4, s[20:23], s63 offen offset:3072 nt
    s_add_u32 s63, s63, 0x8000
    s_and_b32 s63, s63, 0x7ffff
    v_and_b32 v196, v205, v5
    v_and_b32 v197, v205, v6
    v_and_b32 v198, v205, v7
    v_and_b32 v199, v205, v8
    s_waitcnt vmcnt(3)
    v_mfma_f32_16x16x32_bf16 v[28:31], v[192:195], v[64:67], v[28:31]
    s_bitcmp1_b32 s29, 4
    s_cbranch_scc1 L_thv4
    s_waitcnt vmcnt(2)
L_thv4:
    buffer_load_dwordx4 v[48:51], v36, s[24:27], s63 offen offset:0 nt
    v_and_b32 v192, v206, v5
    v_and_b32 v193, v206, v6
    v_and_b32 v194, v206, v7
    v_and_b32 v195, v206, v8
    s_waitcnt vmcnt(3)
    v_mfma_f32_16x16x32_bf16 v[28:31], v[196:199], v[68:71], v[28:31]
    s_bitcmp1_b32 s29, 5
    s_cbranch_scc1 L_thv5
    s_waitcnt vmcnt(2)
L_thv5:
    buffer_load_dwordx4 v[52:55], v36, s[24:27], s63 offen offset:1024 nt
    v_and_b32 v196, v207, v5
    v_and_b32 v197, v207, v6
    v_and_b32 v198, v207, v7
    v_and_b32 v199, v207, v8
    s_waitcnt vmcnt(3)
    v_mfma_f32_16x16x32_bf16 v[28:31], v[192:195], v[72:75], v[28:31]
    s_bitcmp1_b32 s29, 6
    s_cbranch_scc1 L_thv6
    s_waitcnt vmcnt(2)
L_thv6:
    buffer_load_dwordx4 v[56:59], v36, s[24:27], s63 offen offset:2048 nt
    ds_read_b128 v[204:207], v39 offset:192
    s_waitcnt vmcnt(3)
    v_mfma_f32_16x16x32_bf16 v[28:31], v[196:199], v[76:79], v[28:31]
    s_bitcmp1_b32 s29, 7
    s_cbranch_scc1 L_thv7
    s_waitcnt vmcnt(2)
    s_bitcmp1_b32 s29, 15
    s_cbranch_scc0 L_thv7
    s_waitcnt vmcnt(1)
L_thv7:
    buffer_load_dwordx4 v[60:63], v36, s[24:27], s63 offen offset:3072 nt
    s_add_u32 s63, s63, 0x8000
    s_and_b32 s63, s63, 0x7ffff
    v_add_u32 v39, 128, v39
    s_sub_u32 s56, s56, 1
    s_cmp_lg_u32 s56, 0
    s_cbranch_scc1 L_vloop
    s_nop 4
    ds_write_b128 v37, v[28:31] offset:9728
    s_cmp_lg_u32 s57, 0
    s_cbranch_scc1 L_done
    s_mov_b32 s57, 1
    v_add_u32 v37, 4096, v37
    v_add_u32 v18, 256, v18
    ds_read_b128 v[212:215], v18 offset:0
    s_waitcnt lgkmcnt(0)
    v_cndmask_b32 v176, 0, v212, s[74:75]
    v_cndmask_b32 v177, 0, v213, s[74:75]
    v_cndmask_b32 v178, 0, v214, s[74:75]
    v_cndmask_b32 v179, 0, v215, s[74:75]
    v_cndmask_b32 v180, 0, v212, s[76:77]
    v_cndmask_b32 v181, 0, v213, s[76:77]
    v_cndmask_b32 v182, 0, v214, s[76:77]
    v_cndmask_b32 v183, 0, v215, s[76:77]
    v_cndmask_b32 v184, 0, v212, s[78:79]
    v_cndmask_b32 v185, 0, v213, s[78:79]
    v_cndmask_b32 v186, 0, v214, s[78:79]
    v_cndmask_b32 v187, 0, v215, s[78:79]
    v_cndmask_b32 v188, 0, v212, s[80:81]
    v_cndmask_b32 v189, 0, v213, s[80:81]
    v_cndmask_b32 v190, 0, v214, s[80:81]
    v_cndmask_b32 v191, 0, v215, s[80:81]
    v_mov_b32 v16, 0xff800000
    v_mov_b32 v38, v9
    s_mov_b64 s[20:21], s[24:25]
    s_mov_b32 s56, 8
    s_branch L_kloop
L_done:
    s_waitcnt vmcnt(0) lgkmcnt(0)
    s_barrier
    s_cmp_ge_u32 s60, 6
    s_cbranch_scc1 L_f2
    s_cmp_ge_u32 s60, 2
    s_cbranch_scc1 L_poll1_entry
    s_lshl_b32 s64, s60, 6
    v_mov_b32 v12, s64
    ds_read_b128 v[80:83], v12 offset:17920
    ds_read_b128 v[84:87], v12 offset:17936
    ds_read_b128 v[88:91], v12 offset:17952
    ds_read_b128 v[92:95], v12 offset:17968
    s_lshl_b32 s64, s60, 12
    v_lshl_add_u32 v13, v1, 3, s64
    ds_read_b64 v[96:97], v13 offset:9728
    ds_read_b64 v[98:99], v13 offset:10240
    ds_read_b64 v[100:101], v13 offset:10752
    ds_read_b64 v[102:103], v13 offset:11264
    ds_read_b64 v[104:105], v13 offset:11776
    ds_read_b64 v[106:107], v13 offset:12288
    ds_read_b64 v[108:109], v13 offset:12800
    ds_read_b64 v[110:111], v13 offset:13312
    s_lshl_b32 s64, s61, 13
    s_lshl_b32 s65, s62, 10
    s_add_u32 s64, s64, s65
    s_lshl_b32 s65, s60, 9
    s_add_u32 s64, s64, s65
    v_lshlrev_b32 v13, 3, v1
    s_waitcnt lgkmcnt(8)
    v_max3_f32 v14, v80, v82, v84
    v_max3_f32 v14, v14, v86, v88
    v_max3_f32 v14, v14, v90, v92
    v_max_f32 v14, v14, v94
    v_sub_f32 v80, v80, v14
    v_sub_f32 v82, v82, v14
    v_sub_f32 v84, v84, v14
    v_sub_f32 v86, v86, v14
    v_sub_f32 v88, v88, v14
    v_sub_f32 v90, v90, v14
    v_sub_f32 v92, v92, v14
    v_sub_f32 v94, v94, v14
    v_exp_f32 v80, v80
    v_exp_f32 v82, v82
    v_exp_f32 v84, v84
    v_exp_f32 v86, v86
    v_exp_f32 v88, v88
    v_exp_f32 v90, v90
    v_exp_f32 v92, v92
    v_exp_f32 v94, v94
    v_mul_f32 v15, v80, v81
    v_fmac_f32 v15, v82, v83
    v_fmac_f32 v15, v84, v85
    v_fmac_f32 v15, v86, v87
    v_fmac_f32 v15, v88, v89
    v_fmac_f32 v15, v90, v91
    v_fmac_f32 v15, v92, v93
    v_fmac_f32 v15, v94, v95
    v_rcp_f32 v15, v15
    s_waitcnt lgkmcnt(0)
    v_mul_f32 v212, v80, v96
    v_mul_f32 v213, v80, v97
    v_fmac_f32 v212, v82, v98
    v_fmac_f32 v213, v82, v99
    v_fmac_f32 v212, v84, v100
    v_fmac_f32 v213, v84, v101
    v_fmac_f32 v212, v86, v102
    v_fmac_f32 v213, v86, v103
    v_fmac_f32 v212, v88, v104
    v_fmac_f32 v213, v88, v105
    v_fmac_f32 v212, v90, v106
    v_fmac_f32 v213, v90, v107
    v_fmac_f32 v212, v92, v108
    v_fmac_f32 v213, v92, v109
    v_fmac_f32 v212, v94, v110
    v_fmac_f32 v213, v94, v111
    v_mul_f32 v212, v212, v15
    v_mul_f32 v213, v213, v15
    v_bfi_b32 v212, s70, v236, v212
    v_bfi_b32 v213, s70, v236, v213
    buffer_store_dwordx2 v[212:213], v13, s[48:51], s64 offen offset:0
    s_add_u32 s64, s64, 0x480000
    buffer_store_dwordx2 v[212:213], v13, s[48:51], s64 offen sc1
    s_branch L_f2
L_poll1_entry:
    s_mov_b32 s73, 0x20000
    v_lshlrev_b32 v12, 9, v17
    v_lshl_add_u32 v12, v2, 5, v12
    s_sub_u32 s66, s60, 2
    s_lshl_b32 s65, s61, 13
    s_lshl_b32 s67, s66, 7
    s_add_u32 s65, s65, s67
    s_lshl_b32 s66, s66, 10
    v_add_u32 v14, s66, v4
    s_mov_b32 s64, s65
    s_add_u32 s67, s65, 0x480000
L_poll1:
    s_and_b32 s65, s73, 15
    s_cmp_eq_u32 s65, 1
    s_cselect_b32 s65, s67, s64
    buffer_load_dwordx4 v[80:83], v12, s[48:51], s65 offen offset:0 sc1
    buffer_load_dwordx4 v[84:87], v12, s[48:51], s65 offen offset:16 sc1
    s_waitcnt vmcnt(0)
    v_msad_u8 v13, v80, v236, 0
    v_msad_u8 v13, v81, v236, v13
    v_msad_u8 v13, v82, v236, v13
    v_msad_u8 v13, v83, v236, v13
    v_msad_u8 v13, v84, v236, v13
    v_msad_u8 v13, v85, v236, v13
    v_msad_u8 v13, v86, v236, v13
    v_msad_u8 v13, v87, v236, v13
    v_cmp_ne_u32 vcc, 0, v13
    s_cbranch_vccz L_poll1_ok
    s_sleep 1
    s_sub_u32 s73, s73, 1
    s_cbranch_scc0 L_poll1
L_poll1_ok:
    v_cvt_pk_bf16_f32 v88, v80, v81
    v_cvt_pk_bf16_f32 v89, v82, v83
    v_cvt_pk_bf16_f32 v90, v84, v85
    v_cvt_pk_bf16_f32 v91, v86, v87
L_poll1_wr:
    ds_write_b128 v14, v[88:91] offset:18432
L_f2:
    ds_read_b64_tr_b16 v[176:177], v19 offset:22528
    ds_read_b64_tr_b16 v[178:179], v19 offset:23616
    ds_read_b64_tr_b16 v[180:181], v19 offset:31232
    ds_read_b64_tr_b16 v[182:183], v19 offset:32320
    ds_read_b64_tr_b16 v[184:185], v19 offset:39936
    ds_read_b64_tr_b16 v[186:187], v19 offset:41024
    ds_read_b64_tr_b16 v[188:189], v19 offset:48640
    ds_read_b64_tr_b16 v[190:191], v19 offset:49728
    s_lshl_b32 s64, s62, 18
    s_lshl_b32 s65, s61, 13
    s_add_u32 s64, s64, s65
    s_add_u32 s64, s64, 524288
    v_lshlrev_b32 v12, 4, v0
    s_waitcnt lgkmcnt(0)
    s_barrier
    ds_read_b128 v[48:51], v4 offset:18432
    ds_read_b128 v[52:55], v4 offset:19456
    ds_read_b128 v[56:59], v4 offset:20480
    ds_read_b128 v[60:63], v4 offset:21504
    s_waitcnt lgkmcnt(3)
    v_mfma_f32_16x16x32_bf16 v[32:35], v[48:51], v[176:179], 0
    s_waitcnt lgkmcnt(2)
    v_mfma_f32_16x16x32_bf16 v[32:35], v[52:55], v[180:183], v[32:35]
    s_waitcnt lgkmcnt(1)
    v_mfma_f32_16x16x32_bf16 v[32:35], v[56:59], v[184:187], v[32:35]
    s_waitcnt lgkmcnt(0)
    v_mfma_f32_16x16x32_bf16 v[32:35], v[60:63], v[188:191], v[32:35]
    s_nop 7
    v_bfi_b32 v32, s70, v236, v32
    v_bfi_b32 v33, s70, v236, v33
    v_bfi_b32 v34, s70, v236, v34
    v_bfi_b32 v35, s70, v236, v35
    buffer_store_dwordx4 v[32:35], v12, s[48:51], s64 offen sc1
    s_cmp_lg_u32 s60, 0
    s_cbranch_scc1 L_fin
    v_lshlrev_b32 v12, 4, v17
    v_lshl_add_u32 v12, v2, 13, v12
    s_lshl_b32 s64, s62, 18
    s_lshl_b32 s65, s61, 8
    s_add_u32 s64, s64, s65
    s_add_u32 s64, s64, 524288
    s_add_u32 s74, s64, 0
    s_add_u32 s75, s64, 32768
    s_add_u32 s76, s64, 65536
    s_add_u32 s77, s64, 98304
    s_add_u32 s78, s64, 131072
    s_add_u32 s79, s64, 163840
    s_add_u32 s80, s64, 196608
    s_add_u32 s81, s64, 229376
    s_mov_b32 s73, 0x20000
    v_lshlrev_b32 v14, 1, v17
    v_lshl_add_u32 v14, v2, 11, v14
    s_and_b32 s64, s61, 3
    s_lshl_b32 s64, s64, 13
    s_lshl_b32 s65, s62, 8
    s_add_u32 s64, s64, s65
    s_lshr_b32 s65, s61, 2
    s_lshl_b32 s65, s65, 5
    s_add_u32 s64, s64, s65
    s_mov_b32 s66, 0xff
L_poll2:
    s_bitcmp1_b32 s66, 0
    s_cbranch_scc0 L_s2a0
    buffer_load_dwordx4 v[96:99], v12, s[48:51], s74 offen sc1
L_s2a0:
    s_bitcmp1_b32 s66, 1
    s_cbranch_scc0 L_s2a1
    buffer_load_dwordx4 v[100:103], v12, s[48:51], s75 offen sc1
L_s2a1:
    s_bitcmp1_b32 s66, 2
    s_cbranch_scc0 L_s2a2
    buffer_load_dwordx4 v[104:107], v12, s[48:51], s76 offen sc1
L_s2a2:
    s_bitcmp1_b32 s66, 3
    s_cbranch_scc0 L_s2a3
    buffer_load_dwordx4 v[108:111], v12, s[48:51], s77 offen sc1
L_s2a3:
    s_bitcmp1_b32 s66, 4
    s_cbranch_scc0 L_s2a4
    buffer_load_dwordx4 v[112:115], v12, s[48:51], s78 offen sc1
L_s2a4:
    s_bitcmp1_b32 s66, 5
    s_cbranch_scc0 L_s2a5
    buffer_load_dwordx4 v[116:119], v12, s[48:51], s79 offen sc1
L_s2a5:
    s_bitcmp1_b32 s66, 6
    s_cbranch_scc0 L_s2a6
    buffer_load_dwordx4 v[120:123], v12, s[48:51], s80 offen sc1
L_s2a6:
    s_bitcmp1_b32 s66, 7
    s_cbranch_scc0 L_s2a7
    buffer_load_dwordx4 v[124:127], v12, s[48:51], s81 offen sc1
L_s2a7:
    s_waitcnt vmcnt(0)
    s_bitcmp1_b32 s66, 0
    s_cbranch_scc0 L_s2b0
    v_msad_u8 v13, v96, v236, 0
    v_msad_u8 v13, v97, v236, v13
    v_msad_u8 v13, v98, v236, v13
    v_msad_u8 v13, v99, v236, v13
    v_cmp_ne_u32 vcc, 0, v13
    s_cbranch_vccnz L_s2b0
    s_bitset0_b32 s66, 0
L_s2b0:
    s_bitcmp1_b32 s66, 1
    s_cbranch_scc0 L_s2b1
    v_msad_u8 v13, v100, v236, 0
    v_msad_u8 v13, v101, v236, v13
    v_msad_u8 v13, v102, v236, v13
    v_msad_u8 v13, v103, v236, v13
    v_cmp_ne_u32 vcc, 0, v13
    s_cbranch_vccnz L_s2b1
    s_bitset0_b32 s66, 1
L_s2b1:
    s_bitcmp1_b32 s66, 2
    s_cbranch_scc0 L_s2b2
    v_msad_u8 v13, v104, v236, 0
    v_msad_u8 v13, v105, v236, v13
    v_msad_u8 v13, v106, v236, v13
    v_msad_u8 v13, v107, v236, v13
    v_cmp_ne_u32 vcc, 0, v13
    s_cbranch_vccnz L_s2b2
    s_bitset0_b32 s66, 2
L_s2b2:
    s_bitcmp1_b32 s66, 3
    s_cbranch_scc0 L_s2b3
    v_msad_u8 v13, v108, v236, 0
    v_msad_u8 v13, v109, v236, v13
    v_msad_u8 v13, v110, v236, v13
    v_msad_u8 v13, v111, v236, v13
    v_cmp_ne_u32 vcc, 0, v13
    s_cbranch_vccnz L_s2b3
    s_bitset0_b32 s66, 3
L_s2b3:
    s_bitcmp1_b32 s66, 4
    s_cbranch_scc0 L_s2b4
    v_msad_u8 v13, v112, v236, 0
    v_msad_u8 v13, v113, v236, v13
    v_msad_u8 v13, v114, v236, v13
    v_msad_u8 v13, v115, v236, v13
    v_cmp_ne_u32 vcc, 0, v13
    s_cbranch_vccnz L_s2b4
    s_bitset0_b32 s66, 4
L_s2b4:
    s_bitcmp1_b32 s66, 5
    s_cbranch_scc0 L_s2b5
    v_msad_u8 v13, v116, v236, 0
    v_msad_u8 v13, v117, v236, v13
    v_msad_u8 v13, v118, v236, v13
    v_msad_u8 v13, v119, v236, v13
    v_cmp_ne_u32 vcc, 0, v13
    s_cbranch_vccnz L_s2b5
    s_bitset0_b32 s66, 5
L_s2b5:
    s_bitcmp1_b32 s66, 6
    s_cbranch_scc0 L_s2b6
    v_msad_u8 v13, v120, v236, 0
    v_msad_u8 v13, v121, v236, v13
    v_msad_u8 v13, v122, v236, v13
    v_msad_u8 v13, v123, v236, v13
    v_cmp_ne_u32 vcc, 0, v13
    s_cbranch_vccnz L_s2b6
    s_bitset0_b32 s66, 6
L_s2b6:
    s_bitcmp1_b32 s66, 7
    s_cbranch_scc0 L_s2b7
    v_msad_u8 v13, v124, v236, 0
    v_msad_u8 v13, v125, v236, v13
    v_msad_u8 v13, v126, v236, v13
    v_msad_u8 v13, v127, v236, v13
    v_cmp_ne_u32 vcc, 0, v13
    s_cbranch_vccnz L_s2b7
    s_bitset0_b32 s66, 7
L_s2b7:
    s_cmp_eq_u32 s66, 0
    s_cbranch_scc1 L_poll2_ok
    s_sub_u32 s73, s73, 1
    s_cbranch_scc0 L_poll2
L_poll2_ok:
    v_add_f32 v176, v96, v112
    v_add_f32 v177, v97, v113
    v_add_f32 v178, v98, v114
    v_add_f32 v179, v99, v115
    v_add_f32 v180, v100, v116
    v_add_f32 v181, v101, v117
    v_add_f32 v182, v102, v118
    v_add_f32 v183, v103, v119
    v_add_f32 v184, v104, v120
    v_add_f32 v185, v105, v121
    v_add_f32 v186, v106, v122
    v_add_f32 v187, v107, v123
    v_add_f32 v188, v108, v124
    v_add_f32 v189, v109, v125
    v_add_f32 v190, v110, v126
    v_add_f32 v191, v111, v127
L_poll2_sum:
    v_add_f32 v176, v176, v184
    v_add_f32 v177, v177, v185
    v_add_f32 v178, v178, v186
    v_add_f32 v179, v179, v187
    v_add_f32 v180, v180, v188
    v_add_f32 v181, v181, v189
    v_add_f32 v182, v182, v190
    v_add_f32 v183, v183, v191
    v_add_f32 v176, v176, v180
    v_add_f32 v177, v177, v181
    v_add_f32 v178, v178, v182
    v_add_f32 v179, v179, v183
    s_nop 0
    v_permlane32_swap_b32 v176, v178
    v_permlane32_swap_b32 v177, v179
    v_add_f32 v176, v176, v178
    v_add_f32 v177, v177, v179
    s_nop 1
    v_permlane16_swap_b32 v176, v177
    v_add_f32 v176, v176, v177
    v_cvt_pk_bf16_f32 v176, v176, v176
    buffer_store_short v176, v14, s[52:55], s64 offen
    s_cmp_lg_u32 s2, 0
    s_cbranch_scc1 L_fin
    s_mov_b32 s64, 0x40000
    s_mov_b64 exec, 1
    buffer_store_dword v236, off, s[48:51], s64 sc1
    s_mov_b64 exec, -1
L_fin:
L_end:
    s_endpgm
.section .rodata,"a"
.p2align 6
.amdhsa_kernel standalone__mha_block_cached__sampling_kernel
  .amdhsa_next_free_vgpr 246
  .amdhsa_next_free_sgpr 102
  .amdhsa_accum_offset 248
  .amdhsa_group_segment_fixed_size 0
  .amdhsa_kernarg_size 64
  .amdhsa_user_sgpr_count 2
  .amdhsa_user_sgpr_kernarg_segment_ptr 1
  .amdhsa_system_sgpr_workgroup_id_x 1
.end_amdhsa_kernel
```
